```python
import torch

def _softmax(x, axis=-1):
    return torch.softmax(x, dim=axis)
def _gelu(x):
    return torch.nn.functional.gelu(x, approximate="tanh")
def _silu(x):
    return torch.nn.functional.silu(x)
def _sigmoid(x):
    return torch.sigmoid(x)
def _layernorm(x, axis=-1, eps=1e-5):
    m = x.mean(dim=axis, keepdim=True)
    v = x.var(dim=axis, keepdim=True, unbiased=False)
    return (x - m) / torch.sqrt(v + eps)
def _scatter_add(tgt, idx, src, axis=0):
    return tgt.clone().index_add_(axis, idx, src)
def _segment_sum(src, seg, n):
    out = torch.zeros((n,) + src.shape[1:], dtype=src.dtype)
    return out.index_add_(0, seg, src)
def _pad(x, pw):
    flat = tuple(v for pair in reversed(pw) for v in pair)
    return torch.nn.functional.pad(x, flat)

kernel_name = 'standalone__sliding_block_cached__decode'

def setup_inputs():

    _w = (lambda a: (lambda t: t.to(torch.bfloat16) if t.is_floating_point() else t)(torch.as_tensor(a)))
    B, Sq, D = 4, 1, 448
    Hq, Hkv, Sk, Dh = 16, 8, 4096, 256
    assert Hq % Hkv == 0, (Hq, Hkv)
    return {
        "x": _w((lambda *s: torch.randn(*s, dtype=torch.bfloat16) * 0.8)(B, Sq, D)),
        "k_cache": _w((lambda *s: torch.randn(*s, dtype=torch.bfloat16) * 0.8)(B, Hkv, Sk, Dh)),
        "v_cache": _w((lambda *s: torch.randn(*s, dtype=torch.bfloat16) * 0.05)(B, Hkv, Sk, Dh)),
        "wq": _w((lambda *s: torch.randn(*s, dtype=torch.bfloat16) * 0.8)(D, Hq * Dh) * (D ** -0.5)),
        "wo": _w((lambda *s: torch.randn(*s, dtype=torch.bfloat16) * 0.05)(Hq * Dh, D) * ((Hq * Dh) ** -0.5)),
    }

def reference(x, k_cache, v_cache, wq, wo):
    B, Sq, D = x.shape
    Hq, Dh = 16, 256
    Hkv, Sk = k_cache.shape[1], k_cache.shape[2]
    W = min(4096, max(256, Sk // 4))
    rep = Hq // Hkv
    q = (lambda x, *d: x.permute(*d))((x @ wq).reshape(B, Sq, Hq, Dh), 0, 2, 1, 3)
    k = (lambda x, n, axis: torch.repeat_interleave(x, n, dim=axis))(k_cache[:, :, Sk - W:, :], rep, axis=1)
    v = (lambda x, n, axis: torch.repeat_interleave(x, n, dim=axis))(v_cache[:, :, Sk - W:, :], rep, axis=1)
    scores = torch.einsum("bhqd,bhkd->bhqk", q, k) * (Dh ** -0.5)
    p = _softmax(scores, axis=-1)
    o = torch.einsum("bhqk,bhkd->bhqd", p, v)
    return (lambda x, *d: x.permute(*d))(o, 0, 2, 1, 3).reshape(B, Sq, Hq * Dh) @ wo
```

```asm
; @launch grid=(256,1,1) block=(512,1,1) lds=43520
.amdgcn_target "amdgcn-amd-amdhsa--gfx950"
.text
.globl standalone__sliding_block_cached__decode_kernel
.p2align 8
.type standalone__sliding_block_cached__decode_kernel,@function
standalone__sliding_block_cached__decode_kernel:
    s_load_dwordx16 s[4:19], s[0:1], 0
    s_cmpk_ge_u32 s2, 0x100
    s_cbranch_scc1 L_end
    v_readfirstlane_b32 s3, v0
    v_and_b32 v2, 63, v0
    v_and_b32 v3, 15, v0
    v_bfe_u32 v4, v0, 4, 2
    v_and_b32 v10, 3, v0
    s_and_b32 s20, s2, 7
    s_lshr_b32 s22, s2, 6
    s_bfe_u32 s24, s2, 0x30003
    s_lshr_b32 s3, s3, 6
    s_cmp_lt_u32 s3, 4
    s_cbranch_scc1 L_k
    s_and_b32 s27, s2, 248
    s_cbranch_scc1 L_nopf
    s_getpc_b64 s[30:31]
L_pc:
    v_lshlrev_b32 v5, 5, v0
    v_subrev_u32 v5, 8192, v5
    v_min_u32 v5, L_codeend-L_pc-4, v5
    global_load_dword v6, v5, s[30:31]
L_nopf:
    s_setprio 3
    v_mov_b32 v8, 0
    v_mov_b32 v9, 0
    ds_write2_b64 v8, v[8:9], v[8:9] offset0:0 offset1:1
    s_and_b32 s33, s3, 3
    s_cmp_eq_u32 s33, 3
    s_cselect_b32 s34, 1, 3
    v_and_b32 v11, s34, v4
    s_mul_i32 s25, s22, 224
    s_lshl_b32 s27, s33, 6
    s_add_u32 s25, s25, s27
    v_mul_u32_u24 v5, 896, v10
    v_lshlrev_b32 v7, 4, v11
    v_add3_u32 v5, v5, v7, s25
    s_lshl3_add_u32 s27, s20, s24
    s_lshl_b32 s27, s27, 7
    s_lshl_b32 s25, s25, 12
    s_add_u32 s25, s25, s27
    v_lshrrev_b32 v7, 3, v2
    v_lshlrev_b32 v7, 13, v7
    v_and_b32 v8, 7, v2
    v_lshlrev_b32 v9, 4, v8
    v_add3_u32 v7, v7, v9, s25
    s_lshl_b32 s27, s33, 12
    s_add_u32 m0, s27, 1024
    s_mov_b32 s25, 64512
    s_lshl_b32 s50, s20, 17
    s_lshr_b32 s21, s2, 3
    s_lshl2_add_u32 s27, s21, s33
    s_cmp_lt_u32 s27, 32
    s_cselect_b32 s30, 31, 15
    s_lshl_b32 s27, s27, 7
    s_add_u32 s27, s27, s50
    s_add_u32 s27, s27, 4096
    v_lshl_add_u32 v12, v8, 14, s27
    s_mov_b32 exec_lo, s30
    s_mov_b32 exec_hi, 0
    s_cmp_eq_u32 s33, 3
    s_waitcnt lgkmcnt(0)
    global_load_dword v1, v12, s[18:19] offset:0 sc1
    s_mov_b64 exec, -1
    s_load_dword s26, s[18:19], s50
    global_load_lds_dwordx4 v7, s[10:11] offset:0 nt
    v_add_u32 v7, s25, v7
    global_load_lds_dwordx4 v7, s[10:11] offset:1024 nt
    s_cbranch_scc1 L_u3
    v_add_u32 v7, s25, v7
    global_load_lds_dwordx4 v7, s[10:11] offset:2048 nt
    v_add_u32 v7, s25, v7
    global_load_lds_dwordx4 v7, s[10:11] offset:3072 nt
L_u3:
    global_load_dwordx4 v[24:27], v5, s[4:5] offset:0
    s_barrier
    s_branch L_qproj
L_k:
    s_lshl3_add_u32 s23, s22, s20
    s_lshl_b32 s23, s23, 21
    s_lshl2_add_u32 s25, s24, s3
    s_lshl_b32 s25, s25, 12
    s_add_u32 s23, s23, s25
    s_lshr_b32 s25, s24, 1
    s_xor_b32 s25, s25, s3
    s_lshl_b32 s25, s25, 17
    s_add_u32 s23, s23, s25
    s_add_u32 s23, s23, 0x180000
    s_mov_b32 s25, 131072
    v_lshrrev_b32 v5, 1, v3
    v_lshlrev_b32 v5, 9, v5
    v_and_b32 v7, 1, v2
    v_lshl_add_u32 v6, v7, 2, v4
    v_lshlrev_b32 v6, 4, v6
    v_add3_u32 v97, v5, v6, s23
    s_waitcnt lgkmcnt(0)
    s_barrier
    global_load_dwordx4 v[100:103], v97, s[6:7] offset:0 nt
    global_load_dwordx4 v[104:107], v97, s[6:7] offset:128 nt
    global_load_dwordx4 v[108:111], v97, s[6:7] offset:256 nt
    s_lshl_b32 s50, s20, 17
    s_load_dword s26, s[18:19], s50
    s_lshr_b32 s21, s2, 3
    s_lshl_b32 s27, s3, 13
    s_lshl_b32 s29, s22, 8
    s_add_u32 s27, s27, s29
    s_add_u32 s27, s27, s50
    s_add_u32 s27, s27, 36864
    v_and_b32 v12, 1, v4
    v_lshrrev_b32 v13, 1, v4
    v_lshlrev_b32 v9, 12, v12
    v_lshl_add_u32 v9, v13, 11, v9
    v_lshlrev_b32 v14, 4, v3
    v_add3_u32 v9, v9, v14, s27
    s_lshr_b32 s27, s3, 1
    s_mul_i32 s27, s27, 576
    s_and_b32 s29, s3, 1
    s_lshl_b32 s29, s29, 8
    s_add_u32 s27, s27, s29
    v_lshlrev_b32 v15, 7, v12
    v_lshl_add_u32 v15, v13, 2, v15
    v_lshlrev_b32 v16, 3, v3
    v_add3_u32 v15, v15, v16, s27
    v_bfe_u32 v6, v2, 3, 1
    v_mul_u32_u24 v17, 576, v6
    v_and_b32 v7, 4, v2
    v_add_u32 v7, v7, v4
    v_lshl_add_u32 v17, v7, 4, v17
    s_lshl_b32 s27, s3, 3
    v_lshl_add_u32 v19, v6, 5, s27
    s_lshl_b32 s27, s3, 11
    v_lshl_add_u32 v36, v2, 4, s27
    s_and_b32 s48, s21, 3
    s_lshr_b32 s49, s21, 2
    s_lshl2_add_u32 s27, s20, s48
    s_lshl2_add_u32 s27, s27, s3
    s_mul_i32 s27, s27, 28672
    s_min_u32 s29, s49, 6
    s_lshl_b32 s29, s29, 7
    s_add_u32 s27, s27, s29
    v_and_b32 v35, 7, v2
    v_lshlrev_b32 v6, 1, v12
    v_xor_b32 v5, v35, v6
    v_lshlrev_b32 v5, 4, v5
    v_lshrrev_b32 v31, 3, v2
    v_mul_u32_u24 v7, 896, v31
    v_xor_b32 v6, 64, v5
    v_add3_u32 v5, v5, v7, s27
    s_add_u32 s27, s27, 6144
    v_add3_u32 v6, v6, v7, s27
    v_add_u32 v7, 12288, v5
    v_add_u32 v8, 12288, v6
    s_lshl_b32 s27, s3, 12
    s_add_u32 m0, s27, 24576
    s_lshl_b32 s27, s3, 13
    s_lshl_b32 s29, s48, 8
    s_add_u32 s27, s27, s29
    s_add_u32 s27, s27, s50
    s_add_u32 s27, s27, 4096
    v_lshlrev_b32 v25, 11, v4
    v_add3_u32 v25, v25, v14, s27
    s_add_u32 s32, s50, 69632
    s_lshl_b32 s27, s3, 10
    s_lshr_b32 s29, s48, 1
    s_lshl_b32 s29, s29, 4
    s_add_u32 s27, s27, s29
    s_add_u32 s27, s27, s32
    v_and_b32 v26, 1, v2
    v_lshl_add_u32 v26, v4, 1, v26
    v_lshl_add_u32 v26, v26, 7, s27
    s_lshl_b32 s27, s21, 7
    s_add_u32 s27, s27, s32
    v_lshl_add_u32 v33, v2, 4, s27
    v_lshlrev_b32 v34, 5, v2
    v_bfe_u32 v11, v2, 2, 2
    v_lshrrev_b32 v27, 1, v11
    v_lshl_add_u32 v27, v12, 1, v27
    v_xor_b32 v27, s3, v27
    v_lshlrev_b32 v27, 5, v27
    v_lshl_add_u32 v27, v11, 7, v27
    v_lshl_add_u32 v27, v4, 10, v27
    v_lshl_add_u32 v27, v10, 3, v27
    s_mul_i32 s27, s3, 320
    v_lshlrev_b32 v29, 3, v12
    v_lshl_add_u32 v29, v13, 2, v29
    v_add3_u32 v29, v29, v14, s27
    v_mul_u32_u24 v30, 320, v11
    v_lshl_add_u32 v30, v4, 4, v30
    s_lshl2_add_u32 s33, s49, s3
    s_mul_i32 s27, s33, 3072
    s_add_u32 s27, s27, 1048576
    v_lshlrev_b32 v31, 8, v31
    v_lshlrev_b32 v35, 3, v35
    v_add3_u32 v31, v31, v35, s27
    s_add_u32 s27, s27, 2048
    v_lshlrev_b32 v32, 8, v4
    v_add3_u32 v32, v32, v35, s27
    s_mov_b32 s60, 0x01800180
    s_mov_b32 s61, s60
    v_mov_b32 v96, 1.0
    s_lshl_b32 s27, s33, 2
    v_mov_b32 v35, s27
    s_lshl_b32 s27, s33, 5
    v_mul_u32_u24 v1, 896, v4
    v_lshlrev_b32 v18, 1, v3
    v_add3_u32 v1, v1, v18, s27
    v_mov_b32 v37, 0
    v_mov_b32 v38, 1
    s_mov_b32 s35, 0x3db8aa3b
    s_getreg_b32 s53, hwreg(HW_REG_XCC_ID, 0, 4)
    s_lshl_b32 s56, s53, 8
    s_and_b32 s56, s56, 0x100
    s_lshl_b32 s57, s53, 7
    s_and_b32 s57, s57, 0x100
    s_lshl_b32 s58, s53, 6
    s_and_b32 s58, s58, 0x100
    s_lshl_b32 s59, s53, 5
    s_and_b32 s59, s59, 0x100
    v_and_b32 v18, 1, v2
    v_lshlrev_b32 v18, 4, v18
    v_mov_b32 v28, 0xffff
    v_lshlrev_b32 v18, v18, v28
    v_bfe_u32 v28, v2, 1, 2
    v_cmp_eq_u32 vcc, 0, v28
    s_nop 1
    v_cndmask_b32 v88, 0, v18, vcc
    v_cmp_eq_u32 vcc, 1, v28
    s_nop 1
    v_cndmask_b32 v89, 0, v18, vcc
    v_cmp_eq_u32 vcc, 2, v28
    s_nop 1
    v_cndmask_b32 v90, 0, v18, vcc
    v_cmp_eq_u32 vcc, 3, v28
    s_nop 1
    v_cndmask_b32 v91, 0, v18, vcc
    s_mov_b32 s62, 0xff00ff00
    s_mov_b32 s63, s62
    global_load_dwordx4 v[112:115], v97, s[6:7] offset:384 nt
    v_xor_b32 v97, s25, v97
    global_load_dwordx4 v[116:119], v97, s[6:7] offset:0 nt
    global_load_dwordx4 v[120:123], v97, s[6:7] offset:128 nt
    global_load_dwordx4 v[124:127], v97, s[6:7] offset:256 nt
    s_waitcnt vmcnt(6)
    global_load_dwordx4 v[128:131], v97, s[6:7] offset:384 nt
    v_xor_b32 v97, 0x60000, v97
    s_waitcnt vmcnt(6)
    global_load_dwordx4 v[132:135], v97, s[6:7] offset:0 nt
    s_waitcnt vmcnt(6)
    global_load_dwordx4 v[136:139], v97, s[6:7] offset:128 nt
    s_waitcnt vmcnt(6)
    global_load_dwordx4 v[140:143], v97, s[6:7] offset:256 nt
    s_waitcnt vmcnt(6)
    global_load_dwordx4 v[144:147], v97, s[6:7] offset:384 nt
    v_xor_b32 v97, s25, v97
    s_waitcnt vmcnt(6)
    global_load_dwordx4 v[148:151], v97, s[6:7] offset:0 nt
    s_waitcnt vmcnt(6)
    global_load_dwordx4 v[152:155], v97, s[6:7] offset:128 nt
    s_waitcnt vmcnt(6)
    global_load_dwordx4 v[156:159], v97, s[6:7] offset:256 nt
    s_waitcnt vmcnt(6)
    global_load_dwordx4 v[160:163], v97, s[6:7] offset:384 nt
    s_waitcnt vmcnt(6)
    global_load_dwordx4 v[40:43], v9, s[18:19] offset:0 sc1
    global_load_dwordx4 v[44:47], v9, s[18:19] offset:1024 sc1
    s_barrier
    s_waitcnt lgkmcnt(0)
    s_add_u32 s26, s26, 0x01010101
    s_bfe_u32 s27, s26, 524288
    s_or_b32 s56, s56, s27
    s_bfe_u32 s27, s26, 524296
    s_or_b32 s57, s57, s27
    s_bfe_u32 s27, s26, 524304
    s_or_b32 s58, s58, s27
    s_bfe_u32 s27, s26, 524312
    s_or_b32 s59, s59, s27
    s_mov_b32 s27, 100000
    s_waitcnt vmcnt(0)
L_qpoll:
    v_xor_b32 v40, s56, v40
    v_xor_b32 v41, s57, v41
    v_xor_b32 v42, s58, v42
    v_xor_b32 v43, s59, v43
    v_xor_b32 v44, s56, v44
    v_xor_b32 v45, s57, v45
    v_xor_b32 v46, s58, v46
    v_xor_b32 v47, s59, v47
    v_or3_b32 v24, v40, v41, v42
    v_or3_b32 v24, v24, v43, v44
    v_or3_b32 v24, v24, v45, v46
    v_or_b32 v24, v24, v47
    v_lshlrev_b32 v24, 23, v24
    v_cmp_ne_u32 vcc, 0, v24
    s_cbranch_vccnz L_qrare
L_qok:
    v_pk_add_f32 v[20:21], v[40:41], v[44:45]
    v_pk_add_f32 v[22:23], v[42:43], v[46:47]
    s_nop 1
    v_permlane32_swap_b32 v20, v22
    v_permlane32_swap_b32 v21, v23
    v_pk_add_f32 v[20:21], v[20:21], v[22:23]
    v_cvt_pk_bf16_f32 v20, v20, v21
    ds_write_b32 v15, v20 offset:40960
    s_mov_b64 exec, 1
    ds_add_u32 v37, v38 offset:0
    s_mov_b64 exec, -1
L_qsync:
    ds_read_b32 v39, v37 offset:0
    s_waitcnt lgkmcnt(0)
    v_readfirstlane_b32 s54, v39
    s_bitcmp1_b32 s54, 2
    s_cbranch_scc0 L_qsync
    s_lshr_b32 s54, s54, 8
    ds_read_b128 v[48:51], v17 offset:40960
    ds_read_b128 v[52:55], v17 offset:41088
    ds_read_b128 v[56:59], v17 offset:41216
    ds_read_b128 v[60:63], v17 offset:41344
    s_waitcnt lgkmcnt(3)
    v_mfma_f32_16x16x32_bf16 v[64:67], v[100:103], v[48:51], 0
    v_mfma_f32_16x16x32_bf16 v[68:71], v[116:119], v[48:51], 0
    v_mfma_f32_16x16x32_bf16 v[72:75], v[132:135], v[48:51], 0
    v_mfma_f32_16x16x32_bf16 v[76:79], v[148:151], v[48:51], 0
    s_waitcnt lgkmcnt(2)
    v_mfma_f32_16x16x32_bf16 v[64:67], v[104:107], v[52:55], v[64:67]
    v_mfma_f32_16x16x32_bf16 v[68:71], v[120:123], v[52:55], v[68:71]
    v_mfma_f32_16x16x32_bf16 v[72:75], v[136:139], v[52:55], v[72:75]
    v_mfma_f32_16x16x32_bf16 v[76:79], v[152:155], v[52:55], v[76:79]
    s_waitcnt lgkmcnt(1)
    v_mfma_f32_16x16x32_bf16 v[64:67], v[108:111], v[56:59], v[64:67]
    v_mfma_f32_16x16x32_bf16 v[68:71], v[124:127], v[56:59], v[68:71]
    v_mfma_f32_16x16x32_bf16 v[72:75], v[140:143], v[56:59], v[72:75]
    v_mfma_f32_16x16x32_bf16 v[76:79], v[156:159], v[56:59], v[76:79]
    s_waitcnt lgkmcnt(0)
    v_mfma_f32_16x16x32_bf16 v[64:67], v[112:115], v[60:63], v[64:67]
    v_mfma_f32_16x16x32_bf16 v[68:71], v[128:131], v[60:63], v[68:71]
    v_mfma_f32_16x16x32_bf16 v[72:75], v[144:147], v[60:63], v[72:75]
    v_mfma_f32_16x16x32_bf16 v[76:79], v[160:163], v[60:63], v[76:79]
    s_nop 4
    v_add_f32_dpp v80, v65, v64 row_shl:4 row_mask:0xf bank_mask:0x5
    v_add_f32_dpp v81, v67, v66 row_shl:4 row_mask:0xf bank_mask:0x5
    v_add_f32_dpp v82, v69, v68 row_shl:4 row_mask:0xf bank_mask:0x5
    v_add_f32_dpp v83, v71, v70 row_shl:4 row_mask:0xf bank_mask:0x5
    v_add_f32_dpp v84, v73, v72 row_shl:4 row_mask:0xf bank_mask:0x5
    v_add_f32_dpp v85, v75, v74 row_shl:4 row_mask:0xf bank_mask:0x5
    v_add_f32_dpp v86, v77, v76 row_shl:4 row_mask:0xf bank_mask:0x5
    v_add_f32_dpp v87, v79, v78 row_shl:4 row_mask:0xf bank_mask:0x5
    v_add_f32_dpp v80, v64, v65 row_shr:4 row_mask:0xf bank_mask:0xa
    v_add_f32_dpp v81, v66, v67 row_shr:4 row_mask:0xf bank_mask:0xa
    v_add_f32_dpp v82, v68, v69 row_shr:4 row_mask:0xf bank_mask:0xa
    v_add_f32_dpp v83, v70, v71 row_shr:4 row_mask:0xf bank_mask:0xa
    v_add_f32_dpp v84, v72, v73 row_shr:4 row_mask:0xf bank_mask:0xa
    v_add_f32_dpp v85, v74, v75 row_shr:4 row_mask:0xf bank_mask:0xa
    v_add_f32_dpp v86, v76, v77 row_shr:4 row_mask:0xf bank_mask:0xa
    v_add_f32_dpp v87, v78, v79 row_shr:4 row_mask:0xf bank_mask:0xa
    v_cvt_pk_bf16_f32 v48, v80, v81
    v_cvt_pk_bf16_f32 v49, v82, v83
    v_cvt_pk_bf16_f32 v50, v84, v85
    v_cvt_pk_bf16_f32 v51, v86, v87
    v_lshlrev_b32 v80, 16, v48
    v_and_b32 v81, 0xffff0000, v48
    v_lshlrev_b32 v82, 16, v49
    v_and_b32 v83, 0xffff0000, v49
    v_lshlrev_b32 v84, 16, v50
    v_and_b32 v85, 0xffff0000, v50
    v_lshlrev_b32 v86, 16, v51
    v_and_b32 v87, 0xffff0000, v51
    v_max3_f32 v22, v80, v81, v82
    v_max3_f32 v22, v22, v83, v84
    v_max3_f32 v22, v22, v85, v86
    v_max_f32 v22, v22, v87
    v_mov_b32 v24, v22
    s_nop 1
    v_permlane32_swap_b32 v22, v24
    v_max_f32 v22, v22, v24
    v_mov_b32 v24, v22
    s_nop 1
    v_permlane16_swap_b32 v22, v24
    v_max_f32 v22, v22, v24
    v_sub_f32 v80, v80, v22
    v_sub_f32 v81, v81, v22
    v_sub_f32 v82, v82, v22
    v_sub_f32 v83, v83, v22
    v_sub_f32 v84, v84, v22
    v_sub_f32 v85, v85, v22
    v_sub_f32 v86, v86, v22
    v_sub_f32 v87, v87, v22
    v_mul_f32 v80, s35, v80
    v_mul_f32 v81, s35, v81
    v_mul_f32 v82, s35, v82
    v_mul_f32 v83, s35, v83
    v_mul_f32 v84, s35, v84
    v_mul_f32 v85, s35, v85
    v_mul_f32 v86, s35, v86
    v_mul_f32 v87, s35, v87
    v_exp_f32 v80, v80
    v_exp_f32 v81, v81
    v_exp_f32 v82, v82
    v_exp_f32 v83, v83
    v_exp_f32 v84, v84
    v_exp_f32 v85, v85
    v_exp_f32 v86, v86
    v_exp_f32 v87, v87
    v_add_f32 v23, v80, v81
    ds_write_b128 v36, v[80:83] offset:16384
    ds_write_b128 v36, v[84:87] offset:17408
    v_add_f32 v23, v23, v82
    v_add_f32 v23, v23, v83
    v_add_f32 v23, v23, v84
    v_add_f32 v23, v23, v85
    v_add_f32 v23, v23, v86
    v_add_f32 v23, v23, v87
    v_mov_b32 v24, v23
    s_nop 1
    v_permlane32_swap_b32 v23, v24
    v_add_f32 v23, v23, v24
    v_mov_b32 v24, v23
    s_nop 1
    v_permlane16_swap_b32 v23, v24
    v_add_f32 v23, v23, v24
    ds_write_b64 v19, v[22:23] offset:64
    v_mov_b32 v38, 1
    s_mov_b64 exec, 1
    ds_add_rtn_u32 v38, v37, v38 offset:8
    s_waitcnt lgkmcnt(0)
    v_readfirstlane_b32 s27, v38
    s_cmp_eq_u32 s27, 3
    s_cbranch_scc0 L_nostat
    s_cmp_lg_u32 s54, 0
    s_cbranch_scc1 L_fill
L_filled:
    s_mov_b64 exec, 3
    ds_read_b128 v[48:51], v34 offset:64
    ds_read_b128 v[52:55], v34 offset:80
    v_mov_b32 v58, s26
    v_mov_b32 v59, s26
    s_waitcnt lgkmcnt(0)
    v_max3_f32 v56, v48, v50, v52
    v_max_f32 v56, v56, v54
    v_sub_f32 v48, v48, v56
    v_sub_f32 v50, v50, v56
    v_sub_f32 v52, v52, v56
    v_sub_f32 v54, v54, v56
    v_mul_f32 v48, s35, v48
    v_mul_f32 v50, s35, v50
    v_mul_f32 v52, s35, v52
    v_mul_f32 v54, s35, v54
    v_exp_f32 v48, v48
    v_exp_f32 v50, v50
    v_exp_f32 v52, v52
    v_exp_f32 v54, v54
    v_mul_f32 v57, v48, v49
    v_fmac_f32 v57, v50, v51
    v_fmac_f32 v57, v52, v53
    v_fmac_f32 v57, v54, v55
    global_store_dwordx4 v33, v[56:59], s[18:19] offset:0
    s_cmp_eq_u32 s54, 0
    s_cbranch_scc1 L_pub1
    s_waitcnt vmcnt(0)
    global_store_dwordx4 v33, v[56:59], s[18:19] offset:0 sc1
L_pub1:
L_nostat:
    s_mov_b64 exec, -1
    s_cmp_ge_u32 s21, 28
    s_barrier
    s_cbranch_scc1 L_kend
    global_load_dwordx3 v[64:66], v26, s[18:19] offset:0 sc1
    global_load_dword v67, v35, s[16:17] offset:0 sc1
    global_load_lds_dwordx4 v5, s[12:13] offset:0 nt
    global_load_lds_dwordx4 v6, s[12:13] offset:1024 nt
    global_load_lds_dwordx4 v7, s[12:13] offset:2048 nt
    global_load_lds_dwordx4 v8, s[12:13] offset:3072 nt
    s_mov_b32 s27, 100000
    s_barrier
    s_waitcnt vmcnt(4)
L_spoll:
    v_cmp_ne_u32 vcc, s26, v66
    v_cmp_eq_u32 s[30:31], 0, v67
    s_or_b64 vcc, vcc, s[30:31]
    s_cbranch_scc1 L_sagain
L_sok:
    v_max_f32_dpp v22, v64, v64 quad_perm:[1,0,3,2] row_mask:0xf bank_mask:0xf
    v_mov_b32 v24, v22
    s_nop 1
    v_permlane32_swap_b32 v22, v24
    v_max_f32 v22, v22, v24
    v_mov_b32 v24, v22
    s_nop 1
    v_permlane16_swap_b32 v22, v24
    v_max_f32 v22, v22, v24
    v_sub_f32 v64, v64, v22
    v_mul_f32 v64, s35, v64
    v_exp_f32 v64, v64
    s_mov_b32 s27, 100000
    v_mul_f32 v65, v64, v65
    s_nop 1
    v_add_f32_dpp v23, v65, v65 quad_perm:[1,0,3,2] row_mask:0xf bank_mask:0xf
    v_mov_b32 v24, v23
    s_nop 1
    v_permlane32_swap_b32 v23, v24
    v_add_f32 v23, v23, v24
    v_mov_b32 v24, v23
    s_nop 1
    v_permlane16_swap_b32 v23, v24
    v_add_f32 v23, v23, v24
    v_rcp_f32 v23, v23
    s_nop 0
    v_mul_f32 v64, v64, v23
    v_cvt_pk_bf16_f32 v65, v64, v64
    v_lshlrev_b32 v66, 16, v65
    v_sub_f32 v64, v64, v66
    v_cvt_pk_bf16_f32 v64, v64, v64
    v_cndmask_b32 v64, v65, v64, s[62:63]
    s_nop 1
    v_and_b32_dpp v80, v64, v88 quad_perm:[0,0,2,2] row_mask:0xf bank_mask:0xf
    v_and_b32_dpp v81, v64, v89 quad_perm:[0,0,2,2] row_mask:0xf bank_mask:0xf
    v_and_b32_dpp v82, v64, v90 quad_perm:[0,0,2,2] row_mask:0xf bank_mask:0xf
    v_and_b32_dpp v83, v64, v91 quad_perm:[0,0,2,2] row_mask:0xf bank_mask:0xf
    v_and_b32_dpp v84, v64, v88 quad_perm:[1,1,3,3] row_mask:0xf bank_mask:0xf
    v_and_b32_dpp v85, v64, v89 quad_perm:[1,1,3,3] row_mask:0xf bank_mask:0xf
    v_and_b32_dpp v86, v64, v90 quad_perm:[1,1,3,3] row_mask:0xf bank_mask:0xf
    v_and_b32_dpp v87, v64, v91 quad_perm:[1,1,3,3] row_mask:0xf bank_mask:0xf
    s_barrier
    global_load_dwordx4 v[72:75], v25, s[18:19] offset:0 sc1
    global_load_dwordx4 v[76:79], v25, s[18:19] offset:1024 sc1
    s_waitcnt vmcnt(2)
    s_barrier
    ds_read_b64_tr_b16 v[116:117], v27 offset:24576
    ds_read_b64_tr_b16 v[118:119], v27 offset:25088
    ds_read_b64_tr_b16 v[120:121], v27 offset:28672
    ds_read_b64_tr_b16 v[122:123], v27 offset:29184
    ds_read_b64_tr_b16 v[124:125], v27 offset:32768
    ds_read_b64_tr_b16 v[126:127], v27 offset:33280
    ds_read_b64_tr_b16 v[128:129], v27 offset:36864
    ds_read_b64_tr_b16 v[130:131], v27 offset:37376
    s_waitcnt vmcnt(1)
L_ocomb:
    v_mfma_f32_16x16x32_bf16 v[92:95], v[80:83], v[72:75], 0
    v_max3_u32 v24, v72, v73, v74
    v_max_u32 v24, v24, v75
    v_cmp_eq_u32 s[52:53], -1, v24
    s_waitcnt vmcnt(0)
    v_mfma_f32_16x16x32_bf16 v[92:95], v[84:87], v[76:79], v[92:95]
    v_max3_u32 v24, v76, v77, v78
    v_max_u32 v24, v24, v79
    v_cmp_eq_u32 s[54:55], -1, v24
    s_or_b64 vcc, s[52:53], s[54:55]
    s_cbranch_scc1 L_oagain
L_ogot:
    s_nop 2
    v_permlane32_swap_b32 v92, v94
    v_permlane32_swap_b32 v93, v95
    v_pk_add_f32 v[92:93], v[92:93], v[94:95]
    v_cvt_pk_bf16_f32 v92, v92, v93
    ds_write_b32 v29, v92 offset:42240
    s_waitcnt lgkmcnt(0)
    s_barrier
    ds_read_b128 v[100:103], v30 offset:42240
    ds_read_b128 v[104:107], v30 offset:42304
    ds_read_b128 v[108:111], v30 offset:42368
    ds_read_b128 v[112:115], v30 offset:42432
    s_waitcnt lgkmcnt(3)
    v_mfma_f32_16x16x32_bf16 v[132:135], v[100:103], v[116:119], 0
    s_waitcnt lgkmcnt(2)
    v_mfma_f32_16x16x32_bf16 v[132:135], v[104:107], v[120:123], v[132:135]
    s_waitcnt lgkmcnt(1)
    v_mfma_f32_16x16x32_bf16 v[132:135], v[108:111], v[124:127], v[132:135]
    s_waitcnt lgkmcnt(0)
    v_mfma_f32_16x16x32_bf16 v[132:135], v[112:115], v[128:131], v[132:135]
    s_mov_b32 vcc_lo, 0x00200020
    s_mov_b32 vcc_hi, 0x00200020
    s_nop 5
    v_cndmask_b32 v136, v132, 1.0, s[60:61]
    v_cndmask_b32_dpp v138, v132, v96, vcc row_shl:1 row_mask:0xf bank_mask:0xf
    v_cvt_f64_f32 v[136:137], v136
    global_atomic_add_f64 v[140:141], v31, v[136:137], s[18:19] sc0 sc1
    v_cvt_f64_f32 v[138:139], v138
    s_mov_b32 exec_lo, 0x00e000e0
    s_mov_b32 exec_hi, 0x00e000e0
    global_atomic_add_f64 v[142:143], v32, v[138:139], s[18:19] sc0 sc1
    s_not_b64 vcc, s[60:61]
    s_or_b32 s27, s21, s3
    s_cbranch_scc0 L_epoch
L_epoch_done:
    s_mov_b64 exec, -1
    s_waitcnt vmcnt(1)
    v_add_f64 v[136:137], v[136:137], v[140:141]
    v_cvt_f32_f64 v136, v[136:137]
    s_waitcnt vmcnt(0)
    v_add_f64 v[138:139], v[138:139], v[142:143]
    v_mov_b32_dpp v24, v136 row_newbcast:7 row_mask:0xf bank_mask:0x3
    v_cvt_f32_f64 v138, v[138:139]
    s_nop 0
    v_mov_b32_dpp v24, v136 row_newbcast:8 row_mask:0xf bank_mask:0xc
    v_cndmask_b32_dpp v136, v138, v136, vcc row_shr:1 row_mask:0xf bank_mask:0xf
    v_cvt_pk_bf16_f32 v136, v136, v136
    v_cndmask_b32_dpp v24, v138, v24, vcc row_newbcast:5 row_mask:0xf bank_mask:0xf
    v_cmp_eq_f32 vcc, 0x42000000, v24
    s_and_b64 exec, exec, vcc
    s_cbranch_scc0 L_kend
    global_store_short v1, v136, s[14:15] offset:0
L_kend:
L_end:
    s_endpgm
L_epoch:
    s_mov_b64 exec, 1
    v_mov_b32 v20, s26
    v_mov_b32 v21, s50
    global_store_dword v21, v20, s[18:19] offset:0
    s_branch L_epoch_done
L_oagain:
    s_sub_u32 s27, s27, 1
    s_cbranch_scc1 L_ogot
    s_cmp_eq_u64 s[52:53], 0
    s_cbranch_scc1 L_tight1
    s_cmp_eq_u64 s[54:55], 0
    s_cbranch_scc1 L_tight0
    s_mov_b64 exec, s[52:53]
    global_load_dwordx4 v[72:75], v25, s[18:19] offset:0 sc1
    s_mov_b64 exec, s[54:55]
    global_load_dwordx4 v[76:79], v25, s[18:19] offset:1024 sc1
    s_mov_b64 exec, -1
    s_waitcnt vmcnt(1)
    s_branch L_ocomb
L_tight0:
    s_mov_b64 exec, s[52:53]
    global_load_dwordx4 v[148:151], v25, s[18:19] offset:0 sc1
L_tloop0:
    global_load_dwordx4 v[152:155], v25, s[18:19] offset:0 sc1
    s_waitcnt vmcnt(1)
    v_max3_u32 v24, v148, v149, v150
    v_max_u32 v24, v24, v151
    v_cmp_eq_u32 vcc, -1, v24
    s_cbranch_vccz L_tgota0
    global_load_dwordx4 v[148:151], v25, s[18:19] offset:0 sc1
    s_sub_u32 s27, s27, 1
    s_waitcnt vmcnt(1)
    v_max3_u32 v24, v152, v153, v154
    v_max_u32 v24, v24, v155
    v_cmp_eq_u32 vcc, -1, v24
    s_cbranch_vccz L_tgotb0
    s_cbranch_scc0 L_tloop0
L_tgotb0:
    v_mov_b64 v[72:73], v[152:153]
    v_mov_b64 v[74:75], v[154:155]
    s_mov_b64 exec, -1
    s_nop 0
    v_mfma_f32_16x16x32_bf16 v[92:95], v[80:83], v[72:75], 0
    v_mfma_f32_16x16x32_bf16 v[92:95], v[84:87], v[76:79], v[92:95]
    s_nop 3
    s_branch L_ogot
L_tgota0:
    v_mov_b64 v[72:73], v[148:149]
    v_mov_b64 v[74:75], v[150:151]
    s_mov_b64 exec, -1
    s_nop 0
    v_mfma_f32_16x16x32_bf16 v[92:95], v[80:83], v[72:75], 0
    v_mfma_f32_16x16x32_bf16 v[92:95], v[84:87], v[76:79], v[92:95]
    s_nop 3
    s_branch L_ogot
L_tight1:
    s_mov_b64 exec, s[54:55]
    global_load_dwordx4 v[148:151], v25, s[18:19] offset:1024 sc1
L_tloop1:
    global_load_dwordx4 v[152:155], v25, s[18:19] offset:1024 sc1
    s_waitcnt vmcnt(1)
    v_max3_u32 v24, v148, v149, v150
    v_max_u32 v24, v24, v151
    v_cmp_eq_u32 vcc, -1, v24
    s_cbranch_vccz L_tgota1
    global_load_dwordx4 v[148:151], v25, s[18:19] offset:1024 sc1
    s_sub_u32 s27, s27, 1
    s_waitcnt vmcnt(1)
    v_max3_u32 v24, v152, v153, v154
    v_max_u32 v24, v24, v155
    v_cmp_eq_u32 vcc, -1, v24
    s_cbranch_vccz L_tgotb1
    s_cbranch_scc0 L_tloop1
L_tgotb1:
    v_mov_b64 v[76:77], v[152:153]
    v_mov_b64 v[78:79], v[154:155]
    s_mov_b64 exec, -1
    v_mfma_f32_16x16x32_bf16 v[92:95], v[80:83], v[72:75], 0
    v_mfma_f32_16x16x32_bf16 v[92:95], v[84:87], v[76:79], v[92:95]
    s_nop 3
    s_branch L_ogot
L_tgota1:
    v_mov_b64 v[76:77], v[148:149]
    v_mov_b64 v[78:79], v[150:151]
    s_mov_b64 exec, -1
    v_mfma_f32_16x16x32_bf16 v[92:95], v[80:83], v[72:75], 0
    v_mfma_f32_16x16x32_bf16 v[92:95], v[84:87], v[76:79], v[92:95]
    s_nop 3
    s_branch L_ogot
L_fill:
    s_mov_b64 exec, -1
    s_lshl_b32 s29, s21, 10
    s_add_u32 s29, s29, s50
    s_add_u32 s29, s29, 4096
    v_lshl_add_u32 v39, v2, 4, s29
    v_mov_b32 v40, -1
    v_mov_b32 v41, -1
    v_mov_b32 v42, -1
    v_mov_b32 v43, -1
    global_store_dwordx4 v39, v[40:43], s[18:19] offset:0 sc1
    s_waitcnt vmcnt(0)
    s_branch L_filled
L_sagain:
    s_sub_u32 s27, s27, 1
    s_cbranch_scc1 L_sok
    global_load_dwordx3 v[64:66], v26, s[18:19] offset:0 sc1
    global_load_dword v67, v35, s[16:17] offset:0 sc1
    s_waitcnt vmcnt(0)
    s_branch L_spoll
L_qrare:
    v_lshlrev_b32 v24, 1, v24
    v_cmp_ne_u32 vcc, 0, v24
    s_cbranch_vccz L_qflush
    s_cmp_eq_u32 s27, 99936
    s_cbranch_scc1 L_qflush
L_qagain:
    s_sub_u32 s27, s27, 1
    s_cbranch_scc1 L_qok
    global_load_dwordx4 v[40:43], v9, s[18:19] offset:0 sc1
    global_load_dwordx4 v[44:47], v9, s[18:19] offset:1024 sc1
    s_waitcnt vmcnt(0)
    s_branch L_qpoll
L_qflush:
    s_lshl2_add_u32 s29, s24, s22
    s_lshl_b32 s29, s29, 10
    s_add_u32 s29, s29, s50
    s_add_u32 s29, s29, 36864
    v_lshl_add_u32 v39, v2, 4, s29
    global_load_dwordx4 v[48:51], v39, s[18:19] offset:0 sc1
    s_waitcnt vmcnt(0)
    global_store_dwordx4 v39, v[48:51], s[18:19] offset:0 sc1
    s_cbranch_vccnz L_qagain
    v_and_b32 v40, 0xfffffe00, v40
    v_and_b32 v41, 0xfffffe00, v41
    v_and_b32 v42, 0xfffffe00, v42
    v_and_b32 v43, 0xfffffe00, v43
    v_and_b32 v44, 0xfffffe00, v44
    v_and_b32 v45, 0xfffffe00, v45
    v_and_b32 v46, 0xfffffe00, v46
    v_and_b32 v47, 0xfffffe00, v47
    v_mov_b32 v38, 0x101
    s_branch L_qok
L_qproj:
    s_lshl2_add_u32 s55, s24, s22
    s_lshl_b32 s55, s55, 10
    s_add_u32 s55, s55, s50
    s_add_u32 s55, s55, 36864
    s_sub_u32 s52, s2, 224
    s_xor_b32 s29, s33, 3
    s_lshl_b32 s29, s29, 8
    s_or_b32 s51, s52, s29
    s_cmp_lt_u32 s51, 28
    s_cbranch_scc0 L_noinit
    v_mov_b32 v28, 0
    v_mov_b32 v29, 0
    v_mov_b32 v30, 0
    v_mov_b32 v31, 0
    s_mul_i32 s29, s52, 3072
    s_add_u32 s29, s29, 1048576
    v_lshrrev_b32 v19, 2, v2
    v_lshlrev_b32 v19, 8, v19
    v_lshlrev_b32 v12, 4, v10
    v_add3_u32 v19, v19, v12, s29
    s_mov_b32 exec_hi, 0xffff
    global_store_dwordx4 v19, v[28:31], s[18:19] offset:0 sc1
    s_mov_b32 exec_hi, -1
L_noinit:
    v_bfe_u32 v12, v2, 2, 2
    v_lshlrev_b32 v5, 7, v12
    v_lshl_add_u32 v5, v10, 3, v5
    v_lshl_add_u32 v5, v11, 10, v5
    v_add_u32 v5, m0, v5
    v_lshlrev_b32 v7, 8, v10
    v_lshl_add_u32 v7, v12, 6, v7
    v_lshlrev_b32 v8, 4, v4
    v_add3_u32 v7, v7, v8, s55
    v_sub_u32 v8, v4, v11
    v_lshl_add_u32 v12, v8, 2, v12
    v_cmp_eq_u32 s[60:61], 0, v12
    v_cmp_eq_u32 s[62:63], 1, v12
    v_cmp_eq_u32 s[64:65], 2, v12
    v_cmp_eq_u32 s[66:67], 3, v12
    s_lshl_b32 s27, s33, 10
    v_lshlrev_b32 v13, 4, v2
    v_add_u32 v14, s27, v13
    v_mov_b32 v15, 0
    v_mov_b32 v16, 1
    v_mov_b32 v17, 0xfffffe00
    s_getreg_b32 s53, hwreg(HW_REG_XCC_ID, 0, 4)
    s_lshl_b32 s56, s53, 8
    s_and_b32 s56, s56, 0x100
    s_lshl_b32 s57, s53, 7
    s_and_b32 s57, s57, 0x100
    s_lshl_b32 s58, s53, 6
    s_and_b32 s58, s58, 0x100
    s_lshl_b32 s59, s53, 5
    s_and_b32 s59, s59, 0x100
    s_waitcnt lgkmcnt(0)
    s_add_u32 s26, s26, 0x01010101
    s_bfe_u32 s27, s26, 524288
    s_or_b32 s56, s56, s27
    s_bfe_u32 s27, s26, 524296
    s_or_b32 s57, s57, s27
    s_bfe_u32 s27, s26, 524304
    s_or_b32 s58, s58, s27
    s_bfe_u32 s27, s26, 524312
    s_or_b32 s59, s59, s27
    s_cmp_lt_u32 s51, 28
    s_waitcnt vmcnt(1)
    s_cbranch_scc1 L_wqin
    s_waitcnt vmcnt(0)
L_wqin:
    ds_read_b64_tr_b16 v[56:57], v5 offset:0
    ds_read_b64_tr_b16 v[58:59], v5 offset:512
    ds_read_b64_tr_b16 v[60:61], v5 offset:32
    ds_read_b64_tr_b16 v[62:63], v5 offset:544
    ds_read_b64_tr_b16 v[64:65], v5 offset:64
    ds_read_b64_tr_b16 v[66:67], v5 offset:576
    ds_read_b64_tr_b16 v[68:69], v5 offset:96
    ds_read_b64_tr_b16 v[70:71], v5 offset:608
    v_cndmask_b32 v40, 0, v24, s[60:61]
    v_cndmask_b32 v41, 0, v25, s[60:61]
    v_cndmask_b32 v42, 0, v26, s[60:61]
    v_cndmask_b32 v43, 0, v27, s[60:61]
    v_cndmask_b32 v44, 0, v24, s[62:63]
    v_cndmask_b32 v45, 0, v25, s[62:63]
    v_cndmask_b32 v46, 0, v26, s[62:63]
    v_cndmask_b32 v47, 0, v27, s[62:63]
    v_cndmask_b32 v48, 0, v24, s[64:65]
    v_cndmask_b32 v49, 0, v25, s[64:65]
    v_cndmask_b32 v50, 0, v26, s[64:65]
    v_cndmask_b32 v51, 0, v27, s[64:65]
    v_cndmask_b32 v52, 0, v24, s[66:67]
    v_cndmask_b32 v53, 0, v25, s[66:67]
    v_cndmask_b32 v54, 0, v26, s[66:67]
    v_cndmask_b32 v55, 0, v27, s[66:67]
    s_waitcnt lgkmcnt(6)
    v_mfma_f32_16x16x32_bf16 v[20:23], v[56:59], v[40:43], 0
    s_waitcnt lgkmcnt(4)
    v_mfma_f32_16x16x32_bf16 v[20:23], v[60:63], v[44:47], v[20:23]
    s_waitcnt lgkmcnt(2)
    v_mfma_f32_16x16x32_bf16 v[20:23], v[64:67], v[48:51], v[20:23]
    s_waitcnt lgkmcnt(0)
    v_mfma_f32_16x16x32_bf16 v[20:23], v[68:71], v[52:55], v[20:23]
    s_nop 7
    ds_write_b128 v14, v[20:23] offset:16384
    s_mov_b64 exec, 1
    ds_add_rtn_u32 v16, v15, v16 offset:4
    s_mov_b64 exec, -1
    s_waitcnt lgkmcnt(0)
    v_readfirstlane_b32 s27, v16
    s_cmp_eq_u32 s27, 3
    s_cbranch_scc0 L_v
    ds_read_b128 v[72:75], v13 offset:16384
    ds_read_b128 v[76:79], v13 offset:17408
    ds_read_b128 v[80:83], v13 offset:18432
    ds_read_b128 v[84:87], v13 offset:19456
    s_waitcnt lgkmcnt(2)
    v_pk_add_f32 v[72:73], v[72:73], v[76:77]
    v_pk_add_f32 v[74:75], v[74:75], v[78:79]
    s_waitcnt lgkmcnt(0)
    v_pk_add_f32 v[80:81], v[80:81], v[84:85]
    v_pk_add_f32 v[82:83], v[82:83], v[86:87]
    v_pk_add_f32 v[72:73], v[72:73], v[80:81]
    v_pk_add_f32 v[74:75], v[74:75], v[82:83]
    v_and_or_b32 v72, v72, v17, s56
    v_and_or_b32 v73, v73, v17, s57
    v_and_or_b32 v74, v74, v17, s58
    v_and_or_b32 v75, v75, v17, s59
    global_store_dwordx4 v7, v[72:75], s[18:19] offset:0
L_v:
    s_lshl2_add_u32 s27, s21, s33
    s_lshl_b32 s27, s27, 8
    s_add_u32 s27, s27, s50
    s_add_u32 s27, s27, 4096
    v_lshlrev_b32 v9, 4, v3
    v_lshlrev_b32 v11, 3, v4
    v_add3_u32 v18, v9, v11, s27
    v_mov_b32 v32, -1
    v_mov_b32 v33, -1
    s_mov_b32 exec_hi, 0
    global_store_dwordx2 v18, v[32:33], s[18:19] offset:0
    s_mov_b32 exec_hi, -1
    s_setprio 0
    s_lshl3_add_u32 s23, s22, s20
    s_lshl_b32 s23, s23, 21
    s_lshl2_add_u32 s25, s24, s33
    s_lshl_b32 s25, s25, 12
    s_add_u32 s23, s23, s25
    s_lshr_b32 s25, s24, 1
    s_xor_b32 s25, s25, s33
    s_lshl_b32 s25, s25, 17
    s_add_u32 s23, s23, s25
    s_add_u32 s23, s23, 0x180000
    s_mov_b32 s25, 131072
    v_lshlrev_b32 v11, 10, v4
    v_add3_u32 v9, v9, v11, s23
    v_and_b32 v16, 1, v2
    v_lshlrev_b32 v16, 4, v16
    v_mov_b32 v17, 0xffff
    v_lshlrev_b32 v16, v16, v17
    v_bfe_u32 v17, v2, 1, 2
    v_cmp_eq_u32 vcc, 0, v17
    s_nop 1
    v_cndmask_b32 v12, 0, v16, vcc
    v_cmp_eq_u32 vcc, 1, v17
    s_nop 1
    v_cndmask_b32 v13, 0, v16, vcc
    v_cmp_eq_u32 vcc, 2, v17
    s_nop 1
    v_cndmask_b32 v14, 0, v16, vcc
    v_cmp_eq_u32 vcc, 3, v17
    s_nop 1
    v_cndmask_b32 v15, 0, v16, vcc
    v_bfe_u32 v16, v2, 3, 1
    v_lshlrev_b32 v25, 5, v16
    s_lshl_b32 s27, s33, 3
    v_add_u32 v26, s27, v25
    s_lshl_b32 s27, s33, 11
    v_lshl_add_u32 v27, v2, 4, s27
    s_and_b32 s31, s33, 1
    s_lshl_b32 s27, s31, 10
    s_lshr_b32 s29, s33, 1
    s_lshl_b32 s29, s29, 9
    s_add_u32 s27, s27, s29
    v_lshl_add_u32 v16, v2, 4, s27
    s_mov_b32 s35, 0x3db8aa3b
    v_mov_b32 v5, 0
    s_cmp_lt_u32 s51, 28
    s_waitcnt vmcnt(0)
    s_cbranch_scc0 L_noflag
    s_lshl_b32 s29, s52, 2
    v_mov_b32 v19, s29
    v_mov_b32 v28, 1
    s_mov_b64 exec, 1
    global_store_dword v19, v28, s[16:17] offset:0 sc1
    s_mov_b64 exec, -1
L_noflag:
    s_barrier
    global_load_dwordx4 v[100:103], v9, s[8:9] offset:0 nt
    global_load_dwordx4 v[104:107], v9, s[8:9] offset:256 nt
    global_load_dwordx4 v[108:111], v9, s[8:9] offset:512 nt
    global_load_dwordx4 v[112:115], v9, s[8:9] offset:768 nt
    v_xor_b32 v9, s25, v9
    global_load_dwordx4 v[116:119], v9, s[8:9] offset:0 nt
    global_load_dwordx4 v[120:123], v9, s[8:9] offset:256 nt
    global_load_dwordx4 v[124:127], v9, s[8:9] offset:512 nt
    global_load_dwordx4 v[128:131], v9, s[8:9] offset:768 nt
    v_xor_b32 v9, 0x60000, v9
    s_waitcnt vmcnt(7)
    global_load_dwordx4 v[132:135], v9, s[8:9] offset:0 nt
    s_waitcnt vmcnt(7)
    global_load_dwordx4 v[136:139], v9, s[8:9] offset:256 nt
    s_waitcnt vmcnt(7)
    global_load_dwordx4 v[140:143], v9, s[8:9] offset:512 nt
    s_waitcnt vmcnt(7)
    global_load_dwordx4 v[144:147], v9, s[8:9] offset:768 nt
    v_xor_b32 v9, s25, v9
    s_waitcnt vmcnt(7)
    global_load_dwordx4 v[148:151], v9, s[8:9] offset:0 nt
    s_waitcnt vmcnt(7)
    global_load_dwordx4 v[152:155], v9, s[8:9] offset:256 nt
    s_waitcnt vmcnt(7)
    global_load_dwordx4 v[156:159], v9, s[8:9] offset:512 nt
    s_waitcnt vmcnt(7)
    global_load_dwordx4 v[160:163], v9, s[8:9] offset:768 nt
    s_setprio 2
    s_barrier
    ds_read_b32 v49, v5 offset:0
    ds_read_b128 v[40:43], v25 offset:64
    ds_read_b128 v[44:47], v25 offset:80
    ds_read_b32 v48, v26 offset:64
    ds_read_b128 v[28:31], v27 offset:16384
    ds_read_b128 v[32:35], v27 offset:17408
    s_waitcnt lgkmcnt(2)
    v_readfirstlane_b32 s54, v49
    v_max3_f32 v24, v40, v42, v44
    v_max_f32 v24, v24, v46
    v_sub_f32 v24, v48, v24
    v_mul_f32 v24, s35, v24
    v_exp_f32 v24, v24
    s_waitcnt lgkmcnt(0)
    v_mul_f32 v28, v28, v24
    v_mul_f32 v29, v29, v24
    v_mul_f32 v30, v30, v24
    v_mul_f32 v31, v31, v24
    v_mul_f32 v32, v32, v24
    v_mul_f32 v33, v33, v24
    v_mul_f32 v34, v34, v24
    v_mul_f32 v35, v35, v24
    v_cvt_pk_bf16_f32 v28, v28, v28
    v_cvt_pk_bf16_f32 v29, v29, v29
    v_cvt_pk_bf16_f32 v30, v30, v30
    v_cvt_pk_bf16_f32 v31, v31, v31
    v_cvt_pk_bf16_f32 v32, v32, v32
    v_cvt_pk_bf16_f32 v33, v33, v33
    v_cvt_pk_bf16_f32 v34, v34, v34
    v_cvt_pk_bf16_f32 v35, v35, v35
    s_lshr_b32 s54, s54, 8
    v_and_b32 v56, v28, v12
    v_and_b32 v57, v28, v13
    v_and_b32 v58, v28, v14
    v_and_b32 v59, v28, v15
    v_and_b32 v60, v29, v12
    v_and_b32 v61, v29, v13
    v_and_b32 v62, v29, v14
    v_and_b32 v63, v29, v15
    v_mfma_f32_16x16x32_bf16 v[88:91], v[56:59], v[100:103], 0
    v_and_b32 v64, v30, v12
    v_and_b32 v65, v30, v13
    v_and_b32 v66, v30, v14
    v_and_b32 v67, v30, v15
    v_mfma_f32_16x16x32_bf16 v[92:95], v[56:59], v[104:107], 0
    v_and_b32 v68, v31, v12
    v_and_b32 v69, v31, v13
    v_and_b32 v70, v31, v14
    v_and_b32 v71, v31, v15
    v_mfma_f32_16x16x32_bf16 v[88:91], v[60:63], v[108:111], v[88:91]
    v_and_b32 v72, v32, v12
    v_and_b32 v73, v32, v13
    v_and_b32 v74, v32, v14
    v_and_b32 v75, v32, v15
    v_mfma_f32_16x16x32_bf16 v[92:95], v[60:63], v[112:115], v[92:95]
    v_and_b32 v76, v33, v12
    v_and_b32 v77, v33, v13
    v_and_b32 v78, v33, v14
    v_and_b32 v79, v33, v15
    v_mfma_f32_16x16x32_bf16 v[88:91], v[64:67], v[116:119], v[88:91]
    v_and_b32 v80, v34, v12
    v_and_b32 v81, v34, v13
    v_and_b32 v82, v34, v14
    v_and_b32 v83, v34, v15
    v_mfma_f32_16x16x32_bf16 v[92:95], v[64:67], v[120:123], v[92:95]
    v_and_b32 v84, v35, v12
    v_and_b32 v85, v35, v13
    v_and_b32 v86, v35, v14
    v_and_b32 v87, v35, v15
    v_mfma_f32_16x16x32_bf16 v[88:91], v[68:71], v[124:127], v[88:91]
    v_mfma_f32_16x16x32_bf16 v[92:95], v[68:71], v[128:131], v[92:95]
    s_waitcnt vmcnt(7)
    v_mfma_f32_16x16x32_bf16 v[88:91], v[72:75], v[132:135], v[88:91]
    s_waitcnt vmcnt(6)
    v_mfma_f32_16x16x32_bf16 v[92:95], v[72:75], v[136:139], v[92:95]
    s_waitcnt vmcnt(5)
    v_mfma_f32_16x16x32_bf16 v[88:91], v[76:79], v[140:143], v[88:91]
    s_waitcnt vmcnt(4)
    v_mfma_f32_16x16x32_bf16 v[92:95], v[76:79], v[144:147], v[92:95]
    s_waitcnt vmcnt(3)
    v_mfma_f32_16x16x32_bf16 v[88:91], v[80:83], v[148:151], v[88:91]
    s_waitcnt vmcnt(2)
    v_mfma_f32_16x16x32_bf16 v[92:95], v[80:83], v[152:155], v[92:95]
    s_waitcnt vmcnt(1)
    v_mfma_f32_16x16x32_bf16 v[88:91], v[84:87], v[156:159], v[88:91]
    s_waitcnt vmcnt(0)
    v_mfma_f32_16x16x32_bf16 v[92:95], v[84:87], v[160:163], v[92:95]
    s_nop 5
    ds_write_b128 v27, v[88:91] offset:16384
    s_nop 0
    ds_write_b128 v27, v[92:95] offset:17408
    s_waitcnt lgkmcnt(0)
    s_barrier
    s_mov_b32 exec_hi, 0
    ds_read_b128 v[40:43], v16 offset:16384
    ds_read_b128 v[44:47], v16 offset:18432
    ds_read_b128 v[48:51], v16 offset:20480
    ds_read_b128 v[52:55], v16 offset:22528
    s_waitcnt lgkmcnt(2)
    v_pk_add_f32 v[40:41], v[40:41], v[44:45]
    v_pk_add_f32 v[42:43], v[42:43], v[46:47]
    s_waitcnt lgkmcnt(0)
    v_pk_add_f32 v[48:49], v[48:49], v[52:53]
    v_pk_add_f32 v[50:51], v[50:51], v[54:55]
    v_pk_add_f32 v[40:41], v[40:41], v[48:49]
    v_pk_add_f32 v[42:43], v[42:43], v[50:51]
    v_cvt_pk_bf16_f32 v40, v40, v41
    v_cvt_pk_bf16_f32 v41, v42, v43
    v_min_u32 v40, -2, v40
    v_min_u32 v41, -2, v41
    global_store_dwordx2 v18, v[40:41], s[18:19] offset:0
    s_barrier
    s_cmp_eq_u32 s54, 0
    s_cbranch_scc1 L_pub2
    s_waitcnt vmcnt(0)
    global_store_dwordx2 v18, v[40:41], s[18:19] offset:0 sc1
L_pub2:
    s_barrier
    s_endpgm
L_codeend:
.section .rodata,"a"
.p2align 6
.amdhsa_kernel standalone__sliding_block_cached__decode_kernel
  .amdhsa_next_free_vgpr 164
  .amdhsa_next_free_sgpr 68
  .amdhsa_accum_offset 164
  .amdhsa_group_segment_fixed_size 0
  .amdhsa_kernarg_size 64
  .amdhsa_user_sgpr_count 2
  .amdhsa_user_sgpr_kernarg_segment_ptr 1
  .amdhsa_system_sgpr_workgroup_id_x 1
  .amdhsa_float_denorm_mode_32 3
.end_amdhsa_kernel
```
